```python
import torch

def _softmax(x, axis=-1):
    return torch.softmax(x, dim=axis)
def _gelu(x):
    return torch.nn.functional.gelu(x, approximate="tanh")
def _silu(x):
    return torch.nn.functional.silu(x)
def _sigmoid(x):
    return torch.sigmoid(x)
def _layernorm(x, axis=-1, eps=1e-5):
    m = x.mean(dim=axis, keepdim=True)
    v = x.var(dim=axis, keepdim=True, unbiased=False)
    return (x - m) / torch.sqrt(v + eps)
def _scatter_add(tgt, idx, src, axis=0):
    return tgt.clone().index_add_(axis, idx, src)
def _segment_sum(src, seg, n):
    out = torch.zeros((n,) + src.shape[1:], dtype=src.dtype)
    return out.index_add_(0, seg, src)
def _pad(x, pw):
    flat = tuple(v for pair in reversed(pw) for v in pair)
    return torch.nn.functional.pad(x, flat)

kernel_name = 'standalone__paged_block_table_kv_radixattention__decode'

def setup_inputs():

    _w = (lambda a: (lambda t: t.to(torch.bfloat16) if t.is_floating_point() else t)(torch.as_tensor(a)))
    B, H, Hkv, Dh = 1, 32, 16, 128
    Lk = 8192
    bs = 16
    nb = max(2, Lk // bs)
    P = max(1, nb // 2)
    n_phys = P + B * (nb - P)
    shared = torch.arange(P, dtype=torch.int64)
    priv = P + torch.arange(B * (nb - P), dtype=torch.int64).reshape(B, nb - P)
    bt = torch.cat([torch.tile(shared[None, :], (B, 1)), priv], dim=1)
    ctx = nb * bs - (torch.arange(1, B + 1, dtype=torch.int64) * 2654435761) % max(1, (nb * bs - P * bs) // 2)
    return {
        "q": _w((lambda *s: torch.randn(*s, dtype=torch.bfloat16) * 0.8)(B, H, Dh)),
        "k_cache": _w((lambda *s: torch.randn(*s, dtype=torch.bfloat16) * 0.8)(n_phys, bs, Hkv, Dh)),
        "v_cache": _w((lambda *s: torch.randn(*s, dtype=torch.bfloat16) * 0.05)(n_phys, bs, Hkv, Dh)),
        "block_table": _w(bt.to(torch.int64)),
        "ctx_lens": _w(torch.as_tensor(ctx).to(torch.int64)),
    }

def reference(q, k_cache, v_cache, block_table, ctx_lens):
    B, H, Dh = q.shape
    n_phys, bs, Hkv, _ = k_cache.shape
    nb = block_table.shape[1]
    Lk = nb * bs
    rep = H // Hkv
    k = k_cache[block_table].reshape(B, Lk, Hkv, Dh)
    v = v_cache[block_table].reshape(B, Lk, Hkv, Dh)
    k = (lambda x, n, axis: torch.repeat_interleave(x, n, dim=axis))(k, rep, axis=2)
    v = (lambda x, n, axis: torch.repeat_interleave(x, n, dim=axis))(v, rep, axis=2)
    scores = torch.einsum("bhd,bkhd->bhk", q, k) * (Dh ** -0.5)
    pos = torch.arange(Lk)
    valid = pos[None, :] < ctx_lens[:, None]
    scores = torch.where(valid[:, None, :], scores, -1e9)
    p = _softmax(scores, axis=-1)
    return torch.einsum("bhk,bkhd->bhd", p, v)
```

```asm
; @launch grid=(256,1,1) block=(1024,1,1) lds=17408
.amdgcn_target "amdgcn-amd-amdhsa--gfx950"
.text
.globl standalone__paged_block_table_kv_radixattention__decode_kernel
.p2align 8
.type standalone__paged_block_table_kv_radixattention__decode_kernel,@function
standalone__paged_block_table_kv_radixattention__decode_kernel:
    s_load_dwordx2 s[8:9], s[0:1], 8
    v_and_b32 v30, 3, v0
    v_lshlrev_b32 v30, 4, v30
    v_and_b32 v3, 48, v0
    v_lshl_or_b32 v30, v3, 2, v30
    v_and_b32 v1, 12, v0
    v_lshl_or_b32 v1, v1, 10, v30
    v_and_b32 v32, 64, v0
    v_lshl_or_b32 v32, v32, 2, v1
    v_lshrrev_b32 v33, 7, v0
    v_lshl_or_b32 v32, v33, 21, v32
    s_and_b32 s36, s2, 7
    s_lshr_b32 s27, s2, 3
    s_lshl_b32 s40, s27, 7
    s_add_u32 s40, s40, s36
    s_lshl_b32 s40, s40, 9
    s_lshl_b32 s10, 1, 25
    s_lshl_b32 s11, 1, 17
    s_movk_i32 s80, 0x4000
    s_waitcnt lgkmcnt(0)
    buffer_load_dwordx4 v[40:43], v32, s[8:11], s40 offen nt
    s_add_u32 s41, s40, s80
    buffer_load_dwordx4 v[44:47], v32, s[8:11], s41 offen nt
    s_add_u32 s42, s41, s80
    buffer_load_dwordx4 v[48:51], v32, s[8:11], s42 offen nt
    s_add_u32 s43, s42, s80
    buffer_load_dwordx4 v[52:55], v32, s[8:11], s43 offen nt
    s_cmpk_ge_u32 s2, 0x100
    s_cbranch_scc1 L_exit
    v_cmp_gt_u32 vcc, 29, v0
    s_getpc_b64 s[82:83]
    v_lshlrev_b32 v35, 7, v0
    s_and_saveexec_b64 s[84:85], vcc
    s_cbranch_execz L_nopf
    global_load_dword v27, v35, s[82:83]
L_nopf:
    s_mov_b64 exec, -1
    s_load_dwordx4 s[16:19], s[0:1], 24
    s_load_dwordx2 s[4:5], s[0:1], 0
    s_load_dwordx2 s[12:13], s[0:1], 16
    s_load_dwordx4 s[20:23], s[0:1], 40
    s_load_dwordx2 s[24:25], s[0:1], 56
    v_readfirstlane_b32 s3, v0
    v_and_b32 v2, 8, v0
    v_lshl_or_b32 v30, v2, 5, v30
    v_and_b32 v2, 15, v0
    v_lshlrev_b32 v2, 4, v2
    v_lshl_or_b32 v2, v3, 8, v2
    v_lshrrev_b32 v3, 4, v3
    s_lshr_b32 s3, s3, 6
    s_and_b32 s26, s3, 1
    s_lshr_b32 s38, s3, 1
    s_lshl1_add_u32 s37, s36, s26
    s_lshl_b32 s28, s37, 8
    s_lshl_b32 s29, s38, 5
    s_add_u32 s48, s29, 256
    s_add_u32 s29, s29, s27
    s_lshl4_add_u32 s39, s26, s27
    s_and_b32 s39, s39, 31
    s_lshl_b32 s80, s29, 2
    s_add_u32 s81, s48, s39
    s_lshl_b32 s81, s81, 2
    s_lshr_b32 s82, s39, 1
    s_add_u32 s82, s82, s48
    s_lshl_b32 s82, s82, 2
    s_lshr_b32 s83, s39, 2
    s_add_u32 s83, s83, s48
    s_lshl_b32 s83, s83, 2
    s_lshl_b32 s72, s37, 9
    v_add_u32 v30, s72, v30
    s_mov_b32 s15, 0x20000
    s_waitcnt lgkmcnt(0)
    s_load_dword s30, s[18:19], 0
    s_load_dword s32, s[16:17], s80
    s_load_dword s33, s[16:17], s81
    s_load_dword s34, s[16:17], s82
    s_load_dword s35, s[16:17], s83
    global_load_dwordx4 v[8:11], v30, s[4:5]
    s_or_b32 s81, s2, s3
    s_cmp_lg_u32 s81, 0
    s_cbranch_scc1 L_nolead
    s_memrealtime s[82:83]
    v_mov_b32 v34, 0
    s_waitcnt lgkmcnt(0)
    s_lshr_b64 s[74:75], s[82:83], 20
    s_and_b32 s82, s82, 0xfffff
    s_and_b32 s74, s74, 0xfffff
    s_bitset1_b32 s82, 31
    s_bitset1_b32 s74, 31
    v_mov_b32 v32, s82
    v_mov_b32 v33, s74
    s_mov_b64 exec, 1
    global_store_dwordx2 v34, v[32:33], s[22:23] sc1
    s_mov_b64 exec, -1
L_nolead:
    s_mov_b32 s82, 0xff800000
    s_mov_b32 s83, 0xceabae43
    s_waitcnt lgkmcnt(0)
    s_max_i32 s30, s30, 0
    s_min_i32 s30, s30, 8192
    s_add_u32 s31, s30, 15
    s_lshr_b32 s31, s31, 4
    s_and_b32 s32, s32, 511
    s_cmp_lt_u32 s29, s31
    s_cselect_b32 s50, s10, 0
    s_cselect_b32 s80, s83, s82
    v_mov_b32 v20, s80
    s_mov_b32 s49, 0
    s_cmp_lg_u32 s38, 7
    s_cbranch_scc1 L_whole
    s_cmpk_le_u32 s31, 496
    s_cselect_b32 s49, 1, 0
    s_cselect_b32 s33, s34, s33
    s_cmpk_le_u32 s31, 488
    s_cselect_b32 s49, 2, s49
    s_cselect_b32 s33, s35, s33
L_whole:
    s_and_b32 s33, s33, 511
    s_lshr_b32 s80, s39, s49
    s_add_u32 s48, s48, s80
    s_lshl_b32 s80, s80, s49
    s_sub_u32 s80, s39, s80
    s_lshr_b32 s51, 4, s49
    s_mul_i32 s80, s80, s51
    s_cmp_lt_u32 s48, s31
    s_cselect_b32 s51, s51, 0
    s_lshl_b32 s72, s48, 2
    s_add_u32 s72, s72, s80
    s_lshl_b32 s72, s72, 2
    s_sub_i32 s72, s30, s72
    s_lshl_b32 s44, s33, 2
    s_add_u32 s44, s44, s80
    s_lshl_b32 s44, s44, 14
    s_add_u32 s44, s44, s28
    s_add_u32 s45, s44, 0x4000
    s_add_u32 s46, s44, 0x8000
    s_add_u32 s47, s44, 0xc000
    s_lshl_b32 s40, s32, 16
    s_add_u32 s40, s40, s28
    s_add_u32 s41, s40, 0x4000
    s_add_u32 s42, s40, 0x8000
    s_add_u32 s43, s40, 0xc000
    s_cmp_eq_u32 s32, s29
    s_cbranch_scc1 L_spec_ok
    s_waitcnt vmcnt(0)
    buffer_load_dwordx4 v[40:43], v1, s[8:11], s40 offen nt
    buffer_load_dwordx4 v[44:47], v1, s[8:11], s41 offen nt
    buffer_load_dwordx4 v[48:51], v1, s[8:11], s42 offen nt
    buffer_load_dwordx4 v[52:55], v1, s[8:11], s43 offen nt
L_spec_ok:
    s_cmp_gt_u32 s51, 0
    s_cselect_b32 s52, 0x2000000, 0
    s_cselect_b32 s80, s83, s82
    s_mov_b32 s10, s52
    v_mov_b32 v21, s80
    buffer_load_dwordx4 v[56:59], v1, s[8:11], s44 offen nt
    s_cmp_gt_u32 s51, 1
    s_cselect_b32 s53, 0x2000000, 0
    s_cselect_b32 s80, s83, s82
    s_mov_b32 s10, s53
    v_mov_b32 v22, s80
    buffer_load_dwordx4 v[60:63], v1, s[8:11], s45 offen nt
    s_cmp_gt_u32 s51, 2
    s_cselect_b32 s54, 0x2000000, 0
    s_cselect_b32 s80, s83, s82
    s_mov_b32 s10, s54
    v_mov_b32 v23, s80
    buffer_load_dwordx4 v[64:67], v1, s[8:11], s46 offen nt
    s_cmp_gt_u32 s51, 3
    s_cselect_b32 s55, 0x2000000, 0
    s_cselect_b32 s80, s83, s82
    s_mov_b32 s10, s55
    v_mov_b32 v24, s80
    buffer_load_dwordx4 v[68:71], v1, s[8:11], s47 offen nt
    v_mov_b32 v37, 0
    s_mov_b32 s14, s50
    s_barrier
    s_cmp_gt_u32 s3, 2
    s_cbranch_scc1 L_notag
    global_load_dwordx2 v[106:107], v37, s[22:23] sc1
L_notag:
    s_cmp_ge_u32 s3, 8
    s_cbranch_scc1 L_vlater
    buffer_load_dwordx4 v[72:75], v2, s[12:15], s40 offen nt
    buffer_load_dwordx4 v[76:79], v2, s[12:15], s41 offen nt
    buffer_load_dwordx4 v[80:83], v2, s[12:15], s42 offen nt
    buffer_load_dwordx4 v[84:87], v2, s[12:15], s43 offen nt
    s_mov_b32 s14, s52
    buffer_load_dwordx4 v[88:91], v2, s[12:15], s44 offen nt
    s_mov_b32 s14, s53
    buffer_load_dwordx4 v[92:95], v2, s[12:15], s45 offen nt
    s_mov_b32 s14, s54
    buffer_load_dwordx4 v[96:99], v2, s[12:15], s46 offen nt
    s_mov_b32 s14, s55
    buffer_load_dwordx4 v[100:103], v2, s[12:15], s47 offen nt
L_vlater:
    s_lshl_b32 s80, s37, 5
    s_add_u32 s80, s80, s27
    s_mul_i32 s80, s80, 1152
    v_and_b32 v25, 63, v0
    v_lshl_add_u32 v25, v25, 4, s80
    v_and_b32 v26, 8, v0
    v_lshl_add_u32 v26, v26, 1, s80
    s_cmp_ge_u32 s3, 2
    s_cbranch_scc1 L_nodummy
    v_mov_b32 v16, 0
    v_mov_b32 v17, 0
    v_mov_b32 v18, 0
    v_mov_b32 v19, 0
    global_store_dwordx4 v25, v[16:19], s[24:25]
    s_mov_b64 exec, 0xff
    global_store_dwordx4 v25, v[16:19], s[24:25] offset:1024
    s_mov_b64 exec, -1
L_nodummy:
    v_mov_b32 v4, 0x3e0293ee
    v_and_b32 v30, 1, v0
    v_lshlrev_b32 v30, 4, v30
    s_mov_b32 s80, 0xffff
    v_lshlrev_b32_e64 v30, v30, s80
    v_bfe_u32 v31, v0, 1, 2
    v_cmp_eq_u32_e64 s[84:85], 0, v31
    v_cmp_eq_u32_e64 s[86:87], 1, v31
    v_cmp_eq_u32_e64 s[88:89], 2, v31
    v_cmp_eq_u32_e64 s[90:91], 3, v31
    v_bfe_u32 v28, v0, 3, 1
    v_lshlrev_b32 v28, 7, v28
    v_cndmask_b32_e64 v12, 0, v30, s[84:85]
    v_cndmask_b32_e64 v13, 0, v30, s[86:87]
    v_cndmask_b32_e64 v14, 0, v30, s[88:89]
    v_cndmask_b32_e64 v15, 0, v30, s[90:91]
    s_lshl_b32 s80, s26, 8
    v_add_u32 v28, s80, v28
    s_lshl_b32 s80, s38, 4
    v_lshl_add_u32 v5, v3, 2, v28
    v_add_u32 v5, s80, v5
    v_and_b32 v30, 7, v0
    v_lshl_add_u32 v28, v30, 4, v28
    v_lshlrev_b32 v29, 4, v0
    s_movk_i32 s74, 0x3ff
    s_lshl_b32 s80, s29, 4
    s_sub_i32 s80, s30, s80
    s_cmp_lt_u32 s3, 8
    s_cbranch_scc1 L_kw0
    s_waitcnt vmcnt(4)
L_kw0:
    s_waitcnt vmcnt(12)
    v_mfma_f32_16x16x32_bf16 v[40:43], v[40:43], v[8:11], 0
    v_mfma_f32_16x16x32_bf16 v[44:47], v[44:47], v[8:11], 0
    v_mfma_f32_16x16x32_bf16 v[48:51], v[48:51], v[8:11], 0
    v_mfma_f32_16x16x32_bf16 v[52:55], v[52:55], v[8:11], 0
    v_cmp_gt_i32_e64 s[84:85], s80, v3
    s_sub_i32 s80, s80, 4
    v_cmp_gt_i32_e64 s[86:87], s80, v3
    s_sub_i32 s80, s80, 4
    v_cmp_gt_i32_e64 s[88:89], s80, v3
    s_sub_i32 s80, s80, 4
    v_cmp_gt_i32_e64 s[90:91], s80, v3
    s_nop 1
    v_mul_f32_dpp v32, v40, v4 quad_perm:[0,0,0,0] row_mask:0xf bank_mask:0xf
    v_mul_f32_dpp v33, v44, v4 quad_perm:[0,0,0,0] row_mask:0xf bank_mask:0xf
    v_mul_f32_dpp v34, v48, v4 quad_perm:[0,0,0,0] row_mask:0xf bank_mask:0xf
    v_mul_f32_dpp v35, v52, v4 quad_perm:[0,0,0,0] row_mask:0xf bank_mask:0xf
    v_fmac_f32_dpp v32, v41, v4 quad_perm:[1,1,1,1] row_mask:0xf bank_mask:0xf
    v_fmac_f32_dpp v33, v45, v4 quad_perm:[1,1,1,1] row_mask:0xf bank_mask:0xf
    v_fmac_f32_dpp v34, v49, v4 quad_perm:[1,1,1,1] row_mask:0xf bank_mask:0xf
    v_fmac_f32_dpp v35, v53, v4 quad_perm:[1,1,1,1] row_mask:0xf bank_mask:0xf
    v_fmac_f32_dpp v32, v42, v4 quad_perm:[2,2,2,2] row_mask:0xf bank_mask:0xf
    v_fmac_f32_dpp v33, v46, v4 quad_perm:[2,2,2,2] row_mask:0xf bank_mask:0xf
    v_fmac_f32_dpp v34, v50, v4 quad_perm:[2,2,2,2] row_mask:0xf bank_mask:0xf
    v_fmac_f32_dpp v35, v54, v4 quad_perm:[2,2,2,2] row_mask:0xf bank_mask:0xf
    v_fmac_f32_dpp v32, v43, v4 quad_perm:[3,3,3,3] row_mask:0xf bank_mask:0xf
    v_fmac_f32_dpp v33, v47, v4 quad_perm:[3,3,3,3] row_mask:0xf bank_mask:0xf
    v_fmac_f32_dpp v34, v51, v4 quad_perm:[3,3,3,3] row_mask:0xf bank_mask:0xf
    v_fmac_f32_dpp v35, v55, v4 quad_perm:[3,3,3,3] row_mask:0xf bank_mask:0xf
    v_cndmask_b32_e64 v32, v20, v32, s[84:85]
    v_cndmask_b32_e64 v33, v20, v33, s[86:87]
    v_cndmask_b32_e64 v34, v20, v34, s[88:89]
    v_cndmask_b32_e64 v35, v20, v35, s[90:91]
    s_cmp_lt_u32 s3, 8
    s_cbranch_scc1 L_kw1
    s_waitcnt vmcnt(0)
L_kw1:
    s_waitcnt vmcnt(8)
    v_mfma_f32_16x16x32_bf16 v[56:59], v[56:59], v[8:11], 0
    v_mfma_f32_16x16x32_bf16 v[60:63], v[60:63], v[8:11], 0
    v_mfma_f32_16x16x32_bf16 v[64:67], v[64:67], v[8:11], 0
    v_mfma_f32_16x16x32_bf16 v[68:71], v[68:71], v[8:11], 0
    s_cmp_gt_u32 s51, 0
    s_cselect_b32 s80, s72, 0
    v_cmp_gt_i32_e64 s[84:85], s80, v3
    s_sub_i32 s72, s72, 4
    s_cmp_gt_u32 s51, 1
    s_cselect_b32 s80, s72, 0
    v_cmp_gt_i32_e64 s[86:87], s80, v3
    s_sub_i32 s72, s72, 4
    s_cmp_gt_u32 s51, 2
    s_cselect_b32 s80, s72, 0
    v_cmp_gt_i32_e64 s[88:89], s80, v3
    s_sub_i32 s72, s72, 4
    s_cmp_gt_u32 s51, 3
    s_cselect_b32 s80, s72, 0
    v_cmp_gt_i32_e64 s[90:91], s80, v3
    s_nop 0
    v_mul_f32_dpp v36, v56, v4 quad_perm:[0,0,0,0] row_mask:0xf bank_mask:0xf
    v_mul_f32_dpp v37, v60, v4 quad_perm:[0,0,0,0] row_mask:0xf bank_mask:0xf
    v_mul_f32_dpp v38, v64, v4 quad_perm:[0,0,0,0] row_mask:0xf bank_mask:0xf
    v_mul_f32_dpp v39, v68, v4 quad_perm:[0,0,0,0] row_mask:0xf bank_mask:0xf
    v_fmac_f32_dpp v36, v57, v4 quad_perm:[1,1,1,1] row_mask:0xf bank_mask:0xf
    v_fmac_f32_dpp v37, v61, v4 quad_perm:[1,1,1,1] row_mask:0xf bank_mask:0xf
    v_fmac_f32_dpp v38, v65, v4 quad_perm:[1,1,1,1] row_mask:0xf bank_mask:0xf
    v_fmac_f32_dpp v39, v69, v4 quad_perm:[1,1,1,1] row_mask:0xf bank_mask:0xf
    v_fmac_f32_dpp v36, v58, v4 quad_perm:[2,2,2,2] row_mask:0xf bank_mask:0xf
    v_fmac_f32_dpp v37, v62, v4 quad_perm:[2,2,2,2] row_mask:0xf bank_mask:0xf
    v_fmac_f32_dpp v38, v66, v4 quad_perm:[2,2,2,2] row_mask:0xf bank_mask:0xf
    v_fmac_f32_dpp v39, v70, v4 quad_perm:[2,2,2,2] row_mask:0xf bank_mask:0xf
    v_fmac_f32_dpp v36, v59, v4 quad_perm:[3,3,3,3] row_mask:0xf bank_mask:0xf
    v_fmac_f32_dpp v37, v63, v4 quad_perm:[3,3,3,3] row_mask:0xf bank_mask:0xf
    v_fmac_f32_dpp v38, v67, v4 quad_perm:[3,3,3,3] row_mask:0xf bank_mask:0xf
    v_fmac_f32_dpp v39, v71, v4 quad_perm:[3,3,3,3] row_mask:0xf bank_mask:0xf
    v_cndmask_b32_e64 v36, v21, v36, s[84:85]
    v_cndmask_b32_e64 v37, v22, v37, s[86:87]
    v_cndmask_b32_e64 v38, v23, v38, s[88:89]
    v_cndmask_b32_e64 v39, v24, v39, s[90:91]
    v_max3_f32 v6, v32, v33, s83
    v_max3_f32 v6, v34, v35, v6
    v_max3_f32 v6, v36, v37, v6
    v_max3_f32 v6, v38, v39, v6
    ds_write_b32 v5, v6 offset:0
    v_and_b32 v30, v106, v107
    v_lshrrev_b32 v108, 10, v106
    v_readfirstlane_b32 s51, v30
    v_lshrrev_b32 v109, 10, v107
    s_waitcnt lgkmcnt(0)
    s_barrier
    s_cmp_lt_u32 s3, 8
    s_cbranch_scc1 L_vdone
    buffer_load_dwordx4 v[72:75], v2, s[12:15], s40 offen nt
    buffer_load_dwordx4 v[76:79], v2, s[12:15], s41 offen nt
    buffer_load_dwordx4 v[80:83], v2, s[12:15], s42 offen nt
    buffer_load_dwordx4 v[84:87], v2, s[12:15], s43 offen nt
    s_mov_b32 s14, s52
    buffer_load_dwordx4 v[88:91], v2, s[12:15], s44 offen nt
    s_mov_b32 s14, s53
    buffer_load_dwordx4 v[92:95], v2, s[12:15], s45 offen nt
    s_mov_b32 s14, s54
    buffer_load_dwordx4 v[96:99], v2, s[12:15], s46 offen nt
    s_mov_b32 s14, s55
    buffer_load_dwordx4 v[100:103], v2, s[12:15], s47 offen nt
L_vdone:
    ds_read_b128 v[40:43], v28 offset:0
    s_waitcnt lgkmcnt(0)
    v_max3_f32 v6, v40, v41, v42
    v_max_f32 v6, v6, v43
    s_nop 1
    v_max_f32_dpp v6, v6, v6 quad_perm:[1,0,3,2] row_mask:0xf bank_mask:0xf
    s_nop 1
    v_max_f32_dpp v6, v6, v6 quad_perm:[2,3,0,1] row_mask:0xf bank_mask:0xf
    s_nop 1
    v_max_f32_dpp v6, v6, v6 row_half_mirror row_mask:0xf bank_mask:0xf
    v_sub_f32 v32, v32, v6
    v_sub_f32 v33, v33, v6
    v_sub_f32 v34, v34, v6
    v_sub_f32 v35, v35, v6
    v_sub_f32 v36, v36, v6
    v_sub_f32 v37, v37, v6
    v_sub_f32 v38, v38, v6
    v_sub_f32 v39, v39, v6
    v_exp_f32 v32, v32
    v_exp_f32 v33, v33
    v_exp_f32 v34, v34
    v_exp_f32 v35, v35
    v_exp_f32 v36, v36
    v_exp_f32 v37, v37
    v_exp_f32 v38, v38
    v_exp_f32 v39, v39
    v_mov_b32 v104, v6
    v_add_f32 v7, v32, v33
    v_add_f32 v7, v7, v34
    v_add_f32 v7, v7, v35
    v_add_f32 v7, v7, v36
    v_add_f32 v7, v7, v37
    v_add_f32 v7, v7, v38
    v_add_f32 v7, v7, v39
    ds_write_b32 v5, v7 offset:512
    v_cvt_pk_bf16_f32 v32, v32, v32
    v_cvt_pk_bf16_f32 v33, v33, v33
    v_cvt_pk_bf16_f32 v34, v34, v34
    v_cvt_pk_bf16_f32 v35, v35, v35
    v_cvt_pk_bf16_f32 v36, v36, v36
    v_cvt_pk_bf16_f32 v37, v37, v37
    v_cvt_pk_bf16_f32 v38, v38, v38
    v_cvt_pk_bf16_f32 v39, v39, v39
    v_and_b32 v40, v12, v32
    v_and_b32 v41, v13, v32
    v_and_b32 v42, v14, v32
    v_and_b32 v43, v15, v32
    v_and_b32 v44, v12, v33
    v_and_b32 v45, v13, v33
    v_and_b32 v46, v14, v33
    v_and_b32 v47, v15, v33
    v_and_b32 v48, v12, v34
    v_and_b32 v49, v13, v34
    v_and_b32 v50, v14, v34
    v_and_b32 v51, v15, v34
    v_and_b32 v52, v12, v35
    v_and_b32 v53, v13, v35
    v_and_b32 v54, v14, v35
    v_and_b32 v55, v15, v35
    v_and_b32 v56, v12, v36
    v_and_b32 v57, v13, v36
    v_and_b32 v58, v14, v36
    v_and_b32 v59, v15, v36
    v_and_b32 v60, v12, v37
    v_and_b32 v61, v13, v37
    v_and_b32 v62, v14, v37
    v_and_b32 v63, v15, v37
    v_and_b32 v64, v12, v38
    v_and_b32 v65, v13, v38
    v_and_b32 v66, v14, v38
    v_and_b32 v67, v15, v38
    v_and_b32 v68, v12, v39
    v_and_b32 v69, v13, v39
    v_and_b32 v70, v14, v39
    v_and_b32 v71, v15, v39
    s_nop 0
    s_waitcnt vmcnt(7)
    v_mfma_f32_16x16x32_bf16 v[16:19], v[40:43], v[72:75], 0
    s_waitcnt vmcnt(6)
    v_mfma_f32_16x16x32_bf16 v[16:19], v[44:47], v[76:79], v[16:19]
    s_waitcnt vmcnt(5)
    v_mfma_f32_16x16x32_bf16 v[16:19], v[48:51], v[80:83], v[16:19]
    s_waitcnt vmcnt(4)
    v_mfma_f32_16x16x32_bf16 v[16:19], v[52:55], v[84:87], v[16:19]
    s_waitcnt vmcnt(3)
    v_mfma_f32_16x16x32_bf16 v[16:19], v[56:59], v[88:91], v[16:19]
    s_waitcnt vmcnt(2)
    v_mfma_f32_16x16x32_bf16 v[16:19], v[60:63], v[92:95], v[16:19]
    s_waitcnt vmcnt(1)
    v_mfma_f32_16x16x32_bf16 v[16:19], v[64:67], v[96:99], v[16:19]
    s_waitcnt vmcnt(0)
    v_mfma_f32_16x16x32_bf16 v[16:19], v[68:71], v[100:103], v[16:19]
    s_nop 7
    ds_write_b128 v29, v[16:19] offset:1024
    s_waitcnt lgkmcnt(0)
    s_barrier
    s_cmp_gt_u32 s3, 2
    s_cbranch_scc1 L_done
    s_cmp_lt_i32 s51, 0
    s_cbranch_scc0 L_waittag
L_tagok:
    s_cmp_eq_u32 s3, 2
    s_cbranch_scc1 L_consume
    ds_read_b128 v[32:35], v28 offset:512
    ds_read_b128 v[44:47], v29 offset:3072
    ds_read_b128 v[48:51], v29 offset:5120
    ds_read_b128 v[52:55], v29 offset:7168
    ds_read_b128 v[56:59], v29 offset:9216
    ds_read_b128 v[60:63], v29 offset:11264
    ds_read_b128 v[64:67], v29 offset:13312
    ds_read_b128 v[68:71], v29 offset:15360
    s_waitcnt lgkmcnt(7)
    v_add_f32 v7, v32, v33
    v_add_f32 v34, v34, v35
    v_add_f32 v7, v7, v34
    s_waitcnt lgkmcnt(6)
    v_pk_add_f32 v[16:17], v[16:17], v[44:45]
    v_pk_add_f32 v[18:19], v[18:19], v[46:47]
    v_add_f32_dpp v7, v7, v7 quad_perm:[1,0,3,2] row_mask:0xf bank_mask:0xf
    s_waitcnt lgkmcnt(5)
    v_pk_add_f32 v[16:17], v[16:17], v[48:49]
    v_pk_add_f32 v[18:19], v[18:19], v[50:51]
    v_add_f32_dpp v7, v7, v7 quad_perm:[2,3,0,1] row_mask:0xf bank_mask:0xf
    s_waitcnt lgkmcnt(4)
    v_pk_add_f32 v[16:17], v[16:17], v[52:53]
    v_pk_add_f32 v[18:19], v[18:19], v[54:55]
    v_add_f32_dpp v105, v7, v7 row_half_mirror row_mask:0xf bank_mask:0xf
    s_waitcnt lgkmcnt(3)
    v_pk_add_f32 v[16:17], v[16:17], v[56:57]
    v_pk_add_f32 v[18:19], v[18:19], v[58:59]
    s_waitcnt lgkmcnt(2)
    v_pk_add_f32 v[16:17], v[16:17], v[60:61]
    v_pk_add_f32 v[18:19], v[18:19], v[62:63]
    s_waitcnt lgkmcnt(1)
    v_pk_add_f32 v[16:17], v[16:17], v[64:65]
    v_pk_add_f32 v[18:19], v[18:19], v[66:67]
    s_waitcnt lgkmcnt(0)
    v_pk_add_f32 v[16:17], v[16:17], v[68:69]
    v_pk_add_f32 v[18:19], v[18:19], v[70:71]
    v_bfi_b32 v16, s74, v106, v16
    v_bfi_b32 v17, s74, v108, v17
    v_bfi_b32 v18, s74, v107, v18
    v_bfi_b32 v19, s74, v109, v19
    global_store_dwordx4 v25, v[16:19], s[24:25]
    s_mov_b64 exec, 0x101
    global_store_dwordx4 v26, v[104:107], s[24:25] offset:1024
    s_mov_b64 exec, -1
    s_add_u32 s80, s24, 1048576
    s_addc_u32 s81, s25, 0
    global_store_dwordx4 v25, v[16:19], s[80:81] sc1
    s_mov_b64 exec, 0x101
    global_store_dwordx4 v26, v[104:107], s[80:81] offset:1024 sc1
    s_mov_b64 exec, -1
    s_branch L_done
L_waittag:
    v_mov_b32 v31, 0
    s_mov_b32 s76, 0
L_waittag_loop:
    s_sleep 8
    global_load_dwordx2 v[106:107], v31, s[22:23] sc1
    s_add_u32 s76, s76, 1
    s_waitcnt vmcnt(0)
    v_and_b32 v30, v106, v107
    v_lshrrev_b32 v108, 10, v106
    v_readfirstlane_b32 s51, v30
    v_lshrrev_b32 v109, 10, v107
    s_cmp_gt_u32 s76, 20000
    s_cbranch_scc1 L_tagok
    s_cmp_lt_i32 s51, 0
    s_cbranch_scc0 L_waittag_loop
    s_branch L_tagok
L_consume:
    s_lshl_b32 s73, s36, 5
    s_add_u32 s73, s73, s27
    s_movk_i32 s80, 1152
    v_bfe_u32 v2, v0, 2, 4
    v_mul_u32_u24 v2, s80, v2
    v_and_b32 v30, 3, v0
    v_lshlrev_b32 v30, 4, v30
    s_and_b32 s81, s73, 15
    s_lshl_b32 s82, s81, 6
    v_add3_u32 v1, v2, v30, s82
    s_lshr_b32 s82, s81, 3
    s_lshl_b32 s82, s82, 4
    v_add_u32 v2, s82, v2
    s_lshr_b32 s44, s73, 4
    s_mul_i32 s44, s44, 36864
    s_add_u32 s45, s44, 18432
    s_mov_b32 s8, s24
    s_mov_b32 s9, s25
    s_mov_b32 s10, 1638400
    v_and_b32 v80, 0x3ff, v106
    v_and_b32 v81, 0x3ff, v108
    v_and_b32 v82, 0x3ff, v107
    v_and_b32 v83, 0x3ff, v109
    s_mov_b32 s76, 0
    s_mov_b64 s[40:41], -1
    s_mov_b64 s[42:43], -1
    s_branch L_pollA
L_pollB:
    s_sleep 4
    s_mov_b64 exec, s[40:41]
    s_cbranch_execz L_skipb0
    buffer_load_dwordx4 v[40:43], v1, s[8:11], s44 offen sc1
    buffer_load_dwordx4 v[48:51], v2, s[8:11], s44 offen offset:1024 sc1
L_skipb0:
    s_mov_b64 exec, s[42:43]
    s_cbranch_execz L_skipb1
    buffer_load_dwordx4 v[44:47], v1, s[8:11], s45 offen sc1
    buffer_load_dwordx4 v[52:55], v2, s[8:11], s45 offen offset:1024 sc1
L_skipb1:
    s_branch L_issued
L_pollA:
    s_mov_b64 exec, s[40:41]
    s_cbranch_execz L_skipa0
    buffer_load_dwordx4 v[40:43], v1, s[8:11], s44 offen nt
    buffer_load_dwordx4 v[48:51], v2, s[8:11], s44 offen offset:1024 nt
L_skipa0:
    s_mov_b64 exec, s[42:43]
    s_cbranch_execz L_skipa1
    buffer_load_dwordx4 v[44:47], v1, s[8:11], s45 offen nt
    buffer_load_dwordx4 v[52:55], v2, s[8:11], s45 offen offset:1024 nt
L_skipa1:
L_issued:
    s_mov_b64 exec, -1
    s_add_u32 s76, s76, 1
    s_cmp_gt_u32 s76, 20000
    s_cbranch_scc1 L_got
    s_waitcnt vmcnt(0)
    v_xor_b32 v72, v40, v80
    v_xor_b32 v73, v41, v81
    v_xor_b32 v74, v42, v82
    v_xor_b32 v75, v43, v83
    v_xor_b32 v9, v50, v106
    v_xor_b32 v10, v51, v107
    v_xor_b32 v76, v44, v80
    v_xor_b32 v77, v45, v81
    v_xor_b32 v78, v46, v82
    v_xor_b32 v79, v47, v83
    v_xor_b32 v13, v54, v106
    v_xor_b32 v14, v55, v107
    v_or3_b32 v8, v72, v73, v74
    v_or3_b32 v12, v76, v77, v78
    v_or_b32 v8, v8, v75
    v_or_b32 v9, v9, v10
    v_or_b32 v12, v12, v79
    v_or_b32 v13, v13, v14
    v_and_or_b32 v8, v8, s74, v9
    v_and_or_b32 v12, v12, s74, v13
    v_cmp_ne_u32_e64 s[40:41], 0, v8
    v_cmp_ne_u32_e64 s[42:43], 0, v12
    v_max_f32 v6, v48, v52
    s_or_b64 s[80:81], s[40:41], s[42:43]
    s_cbranch_scc0 L_got
    s_cmp_lt_u32 s76, 24
    s_cbranch_scc1 L_pollA
    s_cmp_lg_u32 s76, 24
    s_cbranch_scc1 L_pollB
    s_add_u32 s44, s44, 1048576
    s_add_u32 s45, s45, 1048576
    s_branch L_pollB
L_got:
    v_max_f32_dpp v6, v6, v6 row_ror:4 row_mask:0xf bank_mask:0xf
    s_lshr_b32 s82, s73, 3
    s_lshl_b32 s82, s82, 8
    v_max_f32_dpp v6, v6, v6 row_ror:8 row_mask:0xf bank_mask:0xf
    s_and_b32 s83, s73, 3
    v_mov_b32 v8, v6
    s_lshl_b32 s83, s83, 6
    s_add_u32 s82, s82, s83
    v_permlane16_swap_b32 v6, v8
    s_bfe_u32 s83, s73, 0x10002
    v_max_f32 v6, v6, v8
    v_mov_b32 v8, v6
    s_lshl3_add_u32 s82, s83, s82
    v_add_u32 v30, s82, v30
    v_permlane32_swap_b32 v6, v8
    v_bfe_u32 v9, v0, 4, 1
    v_max_f32 v6, v6, v8
    v_sub_f32 v56, v48, v6
    v_sub_f32 v57, v52, v6
    v_exp_f32 v56, v56
    v_exp_f32 v57, v57
    v_lshl_add_u32 v30, v9, 2, v30
    v_bfe_u32 v9, v0, 5, 1
    v_mul_f32 v7, v56, v49
    v_mul_f32 v60, v56, v72
    v_mul_f32 v61, v56, v73
    v_mul_f32 v62, v56, v74
    v_mul_f32 v63, v56, v75
    v_fmac_f32 v7, v57, v53
    v_fmac_f32 v60, v57, v76
    v_fmac_f32 v61, v57, v77
    v_fmac_f32 v62, v57, v78
    v_fmac_f32 v63, v57, v79
    v_mov_b32 v8, v7
    v_lshl_add_u32 v30, v9, 1, v30
    v_permlane32_swap_b32 v60, v61
    v_permlane32_swap_b32 v62, v63
    v_permlane32_swap_b32 v7, v8
    v_add_f32 v60, v60, v61
    v_add_f32 v62, v62, v63
    v_add_f32 v7, v7, v8
    v_mov_b32 v8, v7
    s_mov_b32 s81, 0xceabae41
    v_permlane16_swap_b32 v60, v62
    v_cmp_ge_f32 vcc, s81, v6
    v_permlane16_swap_b32 v7, v8
    v_add_f32 v60, v60, v62
    v_add_f32 v7, v7, v8
    s_nop 0
    v_add_f32_dpp v60, v60, v60 row_ror:4 row_mask:0xf bank_mask:0xf
    v_add_f32_dpp v7, v7, v7 row_ror:4 row_mask:0xf bank_mask:0xf
    s_nop 0
    v_add_f32_dpp v60, v60, v60 row_ror:8 row_mask:0xf bank_mask:0xf
    v_add_f32_dpp v7, v7, v7 row_ror:8 row_mask:0xf bank_mask:0xf
    s_cbranch_vccnz L_slow
L_fin:
    v_rcp_f32 v7, v7
    s_mov_b32 exec_lo, 0x000f000f
    s_mov_b32 exec_hi, 0x000f000f
    v_mul_f32 v60, v60, v7
    v_cvt_pk_bf16_f32 v60, v60, v60
    global_store_short v30, v60, s[20:21]
L_done:
L_exit:
    s_endpgm
L_slow:
    s_cmp_ge_u32 s31, 512
    s_cbranch_scc1 L_fin
    s_lshr_b32 s81, s73, 4
    s_lshl_b32 s81, s81, 8
    s_and_b32 s80, s73, 3
    s_lshl_b32 s80, s80, 6
    s_add_u32 s81, s81, s80
    s_bfe_u32 s80, s73, 0x10002
    s_lshl3_add_u32 s81, s80, s81
    v_bfe_u32 v88, v0, 2, 4
    v_lshlrev_b32 v88, 12, v88
    v_and_b32 v89, 3, v0
    v_lshlrev_b32 v89, 4, v89
    v_add3_u32 v88, v89, v88, s81
    v_mov_b32 v92, 0
    v_mov_b32 v93, 0
    v_mov_b32 v94, 0
    v_mov_b32 v95, 0
    s_mov_b32 s14, 0x2000000
    s_mov_b32 s76, s31
L_slow_loop:
    s_lshl_b32 s80, s76, 2
    s_load_dword s82, s[16:17], s80
    s_waitcnt lgkmcnt(0)
    s_and_b32 s82, s82, 511
    s_lshl_b32 s82, s82, 16
    buffer_load_dwordx2 v[90:91], v88, s[12:15], s82 offen
    s_waitcnt vmcnt(0)
    v_lshlrev_b32 v89, 16, v90
    v_add_f32 v92, v92, v89
    v_and_b32 v89, 0xffff0000, v90
    v_add_f32 v93, v93, v89
    v_lshlrev_b32 v89, 16, v91
    v_add_f32 v94, v94, v89
    v_and_b32 v89, 0xffff0000, v91
    v_add_f32 v95, v95, v89
    s_add_u32 s76, s76, 1
    s_cmp_lt_u32 s76, 512
    s_cbranch_scc1 L_slow_loop
    s_nop 1
    v_permlane32_swap_b32 v92, v93
    v_permlane32_swap_b32 v94, v95
    s_nop 1
    v_add_f32 v92, v92, v93
    v_add_f32 v94, v94, v95
    s_nop 1
    v_permlane16_swap_b32 v92, v94
    s_nop 1
    v_add_f32 v92, v92, v94
    s_nop 1
    v_add_f32_dpp v92, v92, v92 row_ror:4 row_mask:0xf bank_mask:0xf
    s_nop 1
    v_add_f32_dpp v92, v92, v92 row_ror:8 row_mask:0xf bank_mask:0xf
    v_sub_f32 v89, 0xceabae43, v6
    v_exp_f32 v89, v89
    s_sub_u32 s80, 512, s31
    s_lshl_b32 s80, s80, 4
    v_cvt_f32_u32 v90, s80
    v_fmac_f32 v7, v89, v90
    v_fmac_f32 v60, v89, v92
    s_branch L_fin
.section .rodata,"a"
.p2align 6
.amdhsa_kernel standalone__paged_block_table_kv_radixattention__decode_kernel
  .amdhsa_next_free_vgpr 112
  .amdhsa_next_free_sgpr 96
  .amdhsa_accum_offset 112
  .amdhsa_group_segment_fixed_size 0
  .amdhsa_kernarg_size 64
  .amdhsa_user_sgpr_count 2
  .amdhsa_user_sgpr_kernarg_segment_ptr 1
  .amdhsa_system_sgpr_workgroup_id_x 1
.end_amdhsa_kernel
```
